```python
import torch

def _softmax(x, axis=-1):
    return torch.softmax(x, dim=axis)
def _gelu(x):
    return torch.nn.functional.gelu(x, approximate="tanh")
def _silu(x):
    return torch.nn.functional.silu(x)
def _sigmoid(x):
    return torch.sigmoid(x)
def _layernorm(x, axis=-1, eps=1e-5):
    m = x.mean(dim=axis, keepdim=True)
    v = x.var(dim=axis, keepdim=True, unbiased=False)
    return (x - m) / torch.sqrt(v + eps)
def _scatter_add(tgt, idx, src, axis=0):
    return tgt.clone().index_add_(axis, idx, src)
def _segment_sum(src, seg, n):
    out = torch.zeros((n,) + src.shape[1:], dtype=src.dtype)
    return out.index_add_(0, seg, src)
def _pad(x, pw):
    flat = tuple(v for pair in reversed(pw) for v in pair)
    return torch.nn.functional.pad(x, flat)

kernel_name = 'standalone__mha_softmax__sampling'

def setup_inputs():

    _w = (lambda a: (lambda t: t.to(torch.bfloat16) if t.is_floating_point() else t)(torch.as_tensor(a)))
    B, H, Sq, Sk, D = 16, 32, 1, 2048, 128
    return {
        "q": _w((lambda *s: torch.randn(*s, dtype=torch.bfloat16) * 0.8)(B, H, Sq, D)),
        "k": _w((lambda *s: torch.randn(*s, dtype=torch.bfloat16) * 0.8)(B, H, Sk, D)),
        "v": _w((lambda *s: torch.randn(*s, dtype=torch.bfloat16) * 0.05)(B, H, Sk, D)),
    }

def reference(q, k, v):
    scale = q.shape[-1] ** -0.5
    scores = torch.einsum("bhqd,bhkd->bhqk", q, k) * scale
    p = _softmax(scores, axis=-1)
    return torch.einsum("bhqk,bhkd->bhqd", p, v)
```

```asm
; @launch grid=(256,1,1) block=(320,1,1) lds=98304
.amdgcn_target "amdgcn-amd-amdhsa--gfx950"
.text
.globl standalone__mha_softmax__sampling_kernel
.p2align 12
.p2align 8
.type standalone__mha_softmax__sampling_kernel,@function
standalone__mha_softmax__sampling_kernel:
    s_load_dwordx8 s[4:11], s[0:1], 0
    s_load_dwordx2 s[50:51], s[0:1], 40
    s_cmp_ge_u32 s2, 256
    s_cbranch_scc1 L_done
    s_mov_b32 s48, s2
    s_and_b32 s20, s2, 7
    s_lshl_b32 s20, s20, 2
    s_bfe_u32 s21, s2, 0x20003
    s_or_b32 s20, s20, s21
    s_and_b32 s2, s2, 0xe0
    s_or_b32 s2, s2, s20
    v_and_b32 v2, 63, v0
    v_lshrrev_b32 v1, 6, v0
    v_lshlrev_b32 v2, 4, v2
    v_readfirstlane_b32 s28, v1
    v_lshlrev_b32 v3, 12, v1
    v_lshlrev_b32 v41, 2, v1
    s_lshr_b32 s20, s2, 2
    s_lshr_b32 s21, s2, 5
    s_xor_b32 s20, s20, s21
    s_and_b32 s20, s20, 7
    s_and_b32 s21, s2, 32
    s_or_b32 s20, s20, s21
    s_lshl_b32 s20, s20, 12
    v_lshlrev_b32 v1, 11, v1
    s_and_b32 s21, s20, 0x1800
    v_xor_b32 v1, s21, v1
    v_add_u32 v1, v1, v2
    v_lshrrev_b32 v32, 8, v2
    v_lshl_add_u32 v3, v32, 4, v3
    v_and_b32 v2, 0xf0, v2
    s_lshl_b32 s29, s2, 20
    s_lshl_b32 s3, s2, 9
    s_and_b32 s21, s20, 0x12400
    s_xor_b32 s40, s21, 0x0
    s_xor_b32 s41, s21, 0x10000
    s_xor_b32 s42, s21, 0x400
    s_xor_b32 s43, s21, 0x10400
    s_xor_b32 s44, s21, 0x2000
    s_xor_b32 s45, s21, 0x12000
    s_xor_b32 s46, s21, 0x2400
    s_xor_b32 s47, s21, 0x12400
    s_and_b32 s22, s20, 0xec000
    s_mov_b32 s23, 0
    s_add_u32 s21, s29, s22
    s_add_u32 s36, s21, s40
    v_add_u32 v32, s36, v1
    s_add_u32 s36, s21, s41
    v_add_u32 v33, s36, v1
    s_add_u32 s36, s21, s42
    v_add_u32 v34, s36, v1
    s_add_u32 s36, s21, s43
    v_add_u32 v35, s36, v1
    s_add_u32 s36, s21, s44
    v_add_u32 v36, s36, v1
    s_add_u32 s36, s21, s45
    v_add_u32 v37, s36, v1
    s_add_u32 s36, s21, s46
    v_add_u32 v38, s36, v1
    s_add_u32 s36, s21, s47
    v_add_u32 v39, s36, v1
    v_add_u32 v16, s3, v2
    v_mov_b32 v40, 0
    s_mov_b32 s38, 0x3e0293ee
    s_mov_b32 s39, 0x3e0293ee
    s_mov_b32 s18, 81920
    s_mov_b32 s19, 0x00020000
    s_mov_b32 s26, 512
    s_mov_b32 s27, 0x00020000
    s_mov_b32 s49, 0xffff0000
    v_mov_b32 v28, 0xff800000
    s_mov_b32 s32, 0
    s_mov_b32 s33, 0
    s_mov_b64 vcc, -1
    ds_write_b32 v41, v40 offset:33024
    ds_write_b32 v41, v40 offset:33040
    s_cmp_eq_u32 s28, 4
    s_cbranch_scc1 L_ctl
    s_waitcnt lgkmcnt(0)
    global_load_dwordx4 v[4:7], v16, s[4:5]
    global_load_dwordx4 v[44:47], v32, s[6:7] nt
    global_load_dwordx4 v[48:51], v33, s[6:7] nt
    global_load_dwordx4 v[52:55], v34, s[6:7] nt
    global_load_dwordx4 v[56:59], v35, s[6:7] nt
    global_load_dwordx4 v[60:63], v36, s[6:7] nt
    global_load_dwordx4 v[64:67], v37, s[6:7] nt
    global_load_dwordx4 v[68:71], v38, s[6:7] nt
    global_load_dwordx4 v[72:75], v39, s[6:7] nt
    global_load_dwordx4 v[8:11], v16, s[4:5] offset:256
    s_add_u32 s36, s6, s29
    s_addc_u32 s37, s7, 0
    s_add_u32 s30, s8, s29
    s_addc_u32 s31, s9, 0
    s_or_b32 s23, s23, 0xfff13fff
    s_add_u32 s23, s23, 1
    s_and_b32 s23, s23, 0xec000
    s_cselect_b64 s[36:37], s[36:37], s[30:31]
    s_xor_b32 s21, s23, s22
    s_add_u32 s16, s36, s21
    s_addc_u32 s17, s37, 0
    s_add_u32 s24, s10, s3
    s_addc_u32 s25, s11, 0
    s_barrier
L_khead:
    s_mov_b32 s34, 16
L_kloop:
    s_cmp_eq_u32 s33, 2
    ds_read_b32 v42, v41 offset:33040
    s_waitcnt vmcnt(7)
    v_dot2_f32_bf16 v12, v44, v4, 0
    v_dot2_f32_bf16 v12, v45, v5, v12
    v_dot2_f32_bf16 v12, v46, v6, v12
    v_dot2_f32_bf16 v12, v47, v7, v12
    s_waitcnt vmcnt(5)
    s_cbranch_vccnz L_f1
    s_waitcnt vmcnt(4)
    s_cbranch_scc0 L_f1
    s_waitcnt vmcnt(3)
L_f1:
    buffer_load_dwordx4 v[44:47], v1, s[16:19], s40 offen nt
    s_waitcnt vmcnt(7)
    v_dot2_f32_bf16 v13, v48, v4, 0
    v_dot2_f32_bf16 v13, v49, v5, v13
    v_dot2_f32_bf16 v13, v50, v6, v13
    v_dot2_f32_bf16 v13, v51, v7, v13
    s_waitcnt vmcnt(5)
    s_cbranch_vccnz L_f2
    s_waitcnt vmcnt(4)
    s_cbranch_scc0 L_f2
    s_waitcnt vmcnt(3)
L_f2:
    buffer_load_dwordx4 v[48:51], v1, s[16:19], s41 offen nt
    s_waitcnt vmcnt(7)
    v_dot2_f32_bf16 v14, v52, v4, 0
    v_dot2_f32_bf16 v14, v53, v5, v14
    v_dot2_f32_bf16 v14, v54, v6, v14
    v_dot2_f32_bf16 v14, v55, v7, v14
    s_waitcnt vmcnt(5)
    s_cbranch_vccnz L_f3
    s_waitcnt vmcnt(4)
    s_cbranch_scc0 L_f3
    s_waitcnt vmcnt(3)
L_f3:
    buffer_load_dwordx4 v[52:55], v1, s[16:19], s42 offen nt
    s_waitcnt vmcnt(7)
    v_dot2_f32_bf16 v15, v56, v4, 0
    v_dot2_f32_bf16 v15, v57, v5, v15
    v_dot2_f32_bf16 v15, v58, v6, v15
    v_dot2_f32_bf16 v15, v59, v7, v15
    s_waitcnt vmcnt(5)
    s_cbranch_vccnz L_f4
    s_waitcnt vmcnt(4)
    s_cbranch_scc0 L_f4
    s_waitcnt vmcnt(3)
L_f4:
    buffer_load_dwordx4 v[56:59], v1, s[16:19], s43 offen nt
    v_add_f32_dpp v12, v12, v12 row_ror:8 row_mask:0xf bank_mask:0xf
    v_add_f32_dpp v13, v13, v13 row_ror:8 row_mask:0xf bank_mask:0xf
    v_add_f32_dpp v14, v14, v14 row_ror:8 row_mask:0xf bank_mask:0xf
    v_add_f32_dpp v15, v15, v15 row_ror:8 row_mask:0xf bank_mask:0xf
    v_add_f32_dpp v12, v12, v12 row_ror:4 row_mask:0xf bank_mask:0xf
    v_add_f32_dpp v13, v13, v13 row_ror:4 row_mask:0xf bank_mask:0xf
    v_add_f32_dpp v14, v14, v14 row_ror:4 row_mask:0xf bank_mask:0xf
    v_add_f32_dpp v15, v15, v15 row_ror:4 row_mask:0xf bank_mask:0xf
    v_add_f32_dpp v12, v12, v12 row_ror:2 row_mask:0xf bank_mask:0xf
    v_add_f32_dpp v13, v13, v13 row_ror:2 row_mask:0xf bank_mask:0xf
    v_add_f32_dpp v14, v14, v14 row_ror:2 row_mask:0xf bank_mask:0xf
    v_add_f32_dpp v15, v15, v15 row_ror:2 row_mask:0xf bank_mask:0xf
    v_add_f32_dpp v12, v12, v12 row_ror:1 row_mask:0xf bank_mask:0xf
    v_add_f32_dpp v13, v13, v13 row_ror:1 row_mask:0xf bank_mask:0xf
    v_add_f32_dpp v14, v14, v14 row_ror:1 row_mask:0xf bank_mask:0xf
    v_add_f32_dpp v15, v15, v15 row_ror:1 row_mask:0xf bank_mask:0xf
    v_pk_mul_f32 v[12:13], v[12:13], s[38:39]
    v_pk_mul_f32 v[14:15], v[14:15], s[38:39]
    v_max3_f32 v28, v28, v12, v13
    ds_write_b128 v3, v[12:15] offset:0
    v_max3_f32 v28, v28, v14, v15
    s_waitcnt vmcnt(7)
    v_dot2_f32_bf16 v12, v60, v4, 0
    v_dot2_f32_bf16 v12, v61, v5, v12
    v_dot2_f32_bf16 v12, v62, v6, v12
    v_dot2_f32_bf16 v12, v63, v7, v12
    s_waitcnt vmcnt(5)
    s_cbranch_vccnz L_f5
    s_waitcnt vmcnt(4)
    s_cbranch_scc0 L_f5
    s_waitcnt vmcnt(3)
L_f5:
    buffer_load_dwordx4 v[60:63], v1, s[16:19], s44 offen nt
    s_waitcnt vmcnt(7)
    v_dot2_f32_bf16 v13, v64, v4, 0
    v_dot2_f32_bf16 v13, v65, v5, v13
    v_dot2_f32_bf16 v13, v66, v6, v13
    v_dot2_f32_bf16 v13, v67, v7, v13
    s_waitcnt vmcnt(5)
    s_cbranch_vccnz L_f6
    s_waitcnt vmcnt(4)
    s_cbranch_scc0 L_f6
    s_waitcnt vmcnt(3)
L_f6:
    buffer_load_dwordx4 v[64:67], v1, s[16:19], s45 offen nt
    s_waitcnt vmcnt(7)
    v_dot2_f32_bf16 v14, v68, v4, 0
    v_dot2_f32_bf16 v14, v69, v5, v14
    v_dot2_f32_bf16 v14, v70, v6, v14
    v_dot2_f32_bf16 v14, v71, v7, v14
    s_waitcnt vmcnt(5)
    s_cbranch_vccnz L_f7
    s_waitcnt vmcnt(4)
    s_cbranch_scc0 L_f7
    s_waitcnt vmcnt(3)
L_f7:
    buffer_load_dwordx4 v[68:71], v1, s[16:19], s46 offen nt
    s_waitcnt vmcnt(7)
    v_dot2_f32_bf16 v15, v72, v4, 0
    v_dot2_f32_bf16 v15, v73, v5, v15
    v_dot2_f32_bf16 v15, v74, v6, v15
    v_dot2_f32_bf16 v15, v75, v7, v15
    s_waitcnt vmcnt(5)
    s_cbranch_vccnz L_f8
    s_waitcnt vmcnt(4)
    s_cbranch_scc0 L_f8
    s_waitcnt vmcnt(3)
L_f8:
    buffer_load_dwordx4 v[72:75], v1, s[16:19], s47 offen nt
    v_add_f32_dpp v12, v12, v12 row_ror:8 row_mask:0xf bank_mask:0xf
    v_add_f32_dpp v13, v13, v13 row_ror:8 row_mask:0xf bank_mask:0xf
    v_add_f32_dpp v14, v14, v14 row_ror:8 row_mask:0xf bank_mask:0xf
    v_add_f32_dpp v15, v15, v15 row_ror:8 row_mask:0xf bank_mask:0xf
    v_add_f32_dpp v12, v12, v12 row_ror:4 row_mask:0xf bank_mask:0xf
    v_add_f32_dpp v13, v13, v13 row_ror:4 row_mask:0xf bank_mask:0xf
    v_add_f32_dpp v14, v14, v14 row_ror:4 row_mask:0xf bank_mask:0xf
    v_add_f32_dpp v15, v15, v15 row_ror:4 row_mask:0xf bank_mask:0xf
    v_add_f32_dpp v12, v12, v12 row_ror:2 row_mask:0xf bank_mask:0xf
    v_add_f32_dpp v13, v13, v13 row_ror:2 row_mask:0xf bank_mask:0xf
    v_add_f32_dpp v14, v14, v14 row_ror:2 row_mask:0xf bank_mask:0xf
    v_add_f32_dpp v15, v15, v15 row_ror:2 row_mask:0xf bank_mask:0xf
    v_add_f32_dpp v12, v12, v12 row_ror:1 row_mask:0xf bank_mask:0xf
    v_add_f32_dpp v13, v13, v13 row_ror:1 row_mask:0xf bank_mask:0xf
    v_add_f32_dpp v14, v14, v14 row_ror:1 row_mask:0xf bank_mask:0xf
    v_add_f32_dpp v15, v15, v15 row_ror:1 row_mask:0xf bank_mask:0xf
    v_pk_mul_f32 v[12:13], v[12:13], s[38:39]
    v_pk_mul_f32 v[14:15], v[14:15], s[38:39]
    v_max3_f32 v28, v28, v12, v13
    ds_write_b128 v3, v[12:15] offset:64
    v_max3_f32 v28, v28, v14, v15
    v_add_u32 v3, 128, v3
    v_add_u32 v40, 1, v40
    s_waitcnt lgkmcnt(2)
    v_cmp_eq_u32 vcc, 1, v42
    v_readfirstlane_b32 s33, v42
    ds_write_b32 v41, v40 offset:33024
    s_or_b32 s23, s23, 0xfff13fff
    s_add_u32 s23, s23, 1
    s_and_b32 s23, s23, 0xec000
    s_cselect_b64 s[36:37], s[36:37], s[30:31]
    s_xor_b32 s21, s23, s22
    s_add_u32 s16, s36, s21
    s_addc_u32 s17, s37, 0
    s_sub_u32 s34, s34, 1
    s_cmp_lg_u32 s34, 0
    s_cbranch_scc1 L_kloop
    s_cmp_eq_u32 s32, 1
    s_cbranch_scc1 L_kdone
    s_mov_b32 s32, 1
    v_mov_b32 v30, v28
    v_mov_b32 v4, v8
    v_mov_b32 v5, v9
    v_mov_b32 v6, v10
    v_mov_b32 v7, v11
    v_mov_b32 v28, 0xff800000
    s_branch L_khead
L_kdone:
    v_mov_b32 v31, v28
    v_subrev_u32 v3, 4096, v3
    v_mov_b32 v28, v30
    v_lshrrev_b32 v5, 4, v0
    v_lshlrev_b32 v4, 9, v5
    v_lshl_add_u32 v4, v2, 1, v4
    v_lshlrev_b32 v5, 3, v5
    ds_read_b128 v[12:15], v3
    s_mov_b32 s32, 0
    s_mov_b32 s34, 16
L_vhead:
    v_mov_b32 v20, 0
    v_mov_b32 v21, 0
    v_mov_b32 v22, 0
    v_mov_b32 v23, 0
    v_mov_b32 v24, 0
    v_mov_b32 v25, 0
    v_mov_b32 v26, 0
    v_mov_b32 v27, 0
    v_mov_b32 v29, 0
L_vloop:
    s_cmp_eq_u32 s33, 2
    s_waitcnt lgkmcnt(0)
    v_sub_f32 v12, v12, v28
    v_sub_f32 v13, v13, v28
    v_sub_f32 v14, v14, v28
    v_sub_f32 v15, v15, v28
    ds_read_b128 v[16:19], v3 offset:64
    ds_read_b32 v42, v41 offset:33040
    ds_write_b32 v41, v40 offset:33024
    v_add_u32 v40, 1, v40
    v_exp_f32 v12, v12
    v_exp_f32 v13, v13
    v_exp_f32 v14, v14
    v_exp_f32 v15, v15
    s_waitcnt vmcnt(7)
    v_lshlrev_b32 v32, 16, v44
    v_and_b32 v33, s49, v44
    v_lshlrev_b32 v34, 16, v45
    v_and_b32 v35, s49, v45
    v_lshlrev_b32 v36, 16, v46
    v_and_b32 v37, s49, v46
    v_lshlrev_b32 v38, 16, v47
    v_and_b32 v39, s49, v47
    v_pk_fma_f32 v[20:21], v[32:33], v[12:13], v[20:21] op_sel:[0,0,0] op_sel_hi:[1,0,1]
    v_pk_fma_f32 v[22:23], v[34:35], v[12:13], v[22:23] op_sel:[0,0,0] op_sel_hi:[1,0,1]
    v_pk_fma_f32 v[24:25], v[36:37], v[12:13], v[24:25] op_sel:[0,0,0] op_sel_hi:[1,0,1]
    v_pk_fma_f32 v[26:27], v[38:39], v[12:13], v[26:27] op_sel:[0,0,0] op_sel_hi:[1,0,1]
    v_add_f32 v29, v29, v12
    s_waitcnt vmcnt(5)
    s_cbranch_vccnz L_f9
    s_waitcnt vmcnt(4)
    s_cbranch_scc0 L_f9
    s_waitcnt vmcnt(3)
L_f9:
    buffer_load_dwordx4 v[44:47], v1, s[16:19], s40 offen nt
    s_waitcnt vmcnt(7)
    v_lshlrev_b32 v32, 16, v48
    v_and_b32 v33, s49, v48
    v_lshlrev_b32 v34, 16, v49
    v_and_b32 v35, s49, v49
    v_lshlrev_b32 v36, 16, v50
    v_and_b32 v37, s49, v50
    v_lshlrev_b32 v38, 16, v51
    v_and_b32 v39, s49, v51
    v_pk_fma_f32 v[20:21], v[32:33], v[12:13], v[20:21] op_sel:[0,1,0] op_sel_hi:[1,1,1]
    v_pk_fma_f32 v[22:23], v[34:35], v[12:13], v[22:23] op_sel:[0,1,0] op_sel_hi:[1,1,1]
    v_pk_fma_f32 v[24:25], v[36:37], v[12:13], v[24:25] op_sel:[0,1,0] op_sel_hi:[1,1,1]
    v_pk_fma_f32 v[26:27], v[38:39], v[12:13], v[26:27] op_sel:[0,1,0] op_sel_hi:[1,1,1]
    v_add_f32 v29, v29, v13
    s_waitcnt vmcnt(5)
    s_cbranch_vccnz L_f10
    s_waitcnt vmcnt(4)
    s_cbranch_scc0 L_f10
    s_waitcnt vmcnt(3)
L_f10:
    buffer_load_dwordx4 v[48:51], v1, s[16:19], s41 offen nt
    s_waitcnt vmcnt(7)
    v_lshlrev_b32 v32, 16, v52
    v_and_b32 v33, s49, v52
    v_lshlrev_b32 v34, 16, v53
    v_and_b32 v35, s49, v53
    v_lshlrev_b32 v36, 16, v54
    v_and_b32 v37, s49, v54
    v_lshlrev_b32 v38, 16, v55
    v_and_b32 v39, s49, v55
    v_pk_fma_f32 v[20:21], v[32:33], v[14:15], v[20:21] op_sel:[0,0,0] op_sel_hi:[1,0,1]
    v_pk_fma_f32 v[22:23], v[34:35], v[14:15], v[22:23] op_sel:[0,0,0] op_sel_hi:[1,0,1]
    v_pk_fma_f32 v[24:25], v[36:37], v[14:15], v[24:25] op_sel:[0,0,0] op_sel_hi:[1,0,1]
    v_pk_fma_f32 v[26:27], v[38:39], v[14:15], v[26:27] op_sel:[0,0,0] op_sel_hi:[1,0,1]
    v_add_f32 v29, v29, v14
    s_waitcnt vmcnt(5)
    s_cbranch_vccnz L_f11
    s_waitcnt vmcnt(4)
    s_cbranch_scc0 L_f11
    s_waitcnt vmcnt(3)
L_f11:
    buffer_load_dwordx4 v[52:55], v1, s[16:19], s42 offen nt
    s_waitcnt vmcnt(7)
    v_lshlrev_b32 v32, 16, v56
    v_and_b32 v33, s49, v56
    v_lshlrev_b32 v34, 16, v57
    v_and_b32 v35, s49, v57
    v_lshlrev_b32 v36, 16, v58
    v_and_b32 v37, s49, v58
    v_lshlrev_b32 v38, 16, v59
    v_and_b32 v39, s49, v59
    v_pk_fma_f32 v[20:21], v[32:33], v[14:15], v[20:21] op_sel:[0,1,0] op_sel_hi:[1,1,1]
    v_pk_fma_f32 v[22:23], v[34:35], v[14:15], v[22:23] op_sel:[0,1,0] op_sel_hi:[1,1,1]
    v_pk_fma_f32 v[24:25], v[36:37], v[14:15], v[24:25] op_sel:[0,1,0] op_sel_hi:[1,1,1]
    v_pk_fma_f32 v[26:27], v[38:39], v[14:15], v[26:27] op_sel:[0,1,0] op_sel_hi:[1,1,1]
    v_add_f32 v29, v29, v15
    s_waitcnt vmcnt(5)
    s_cbranch_vccnz L_f12
    s_waitcnt vmcnt(4)
    s_cbranch_scc0 L_f12
    s_waitcnt vmcnt(3)
L_f12:
    buffer_load_dwordx4 v[56:59], v1, s[16:19], s43 offen nt
    s_waitcnt lgkmcnt(0)
    v_cmp_eq_u32 vcc, 1, v42
    v_readfirstlane_b32 s33, v42
    s_cmp_eq_u32 s33, 2
    v_sub_f32 v16, v16, v28
    v_sub_f32 v17, v17, v28
    v_sub_f32 v18, v18, v28
    v_sub_f32 v19, v19, v28
    ds_read_b128 v[12:15], v3 offset:128
    v_exp_f32 v16, v16
    v_exp_f32 v17, v17
    v_exp_f32 v18, v18
    v_exp_f32 v19, v19
    s_waitcnt vmcnt(7)
    v_lshlrev_b32 v32, 16, v60
    v_and_b32 v33, s49, v60
    v_lshlrev_b32 v34, 16, v61
    v_and_b32 v35, s49, v61
    v_lshlrev_b32 v36, 16, v62
    v_and_b32 v37, s49, v62
    v_lshlrev_b32 v38, 16, v63
    v_and_b32 v39, s49, v63
    v_pk_fma_f32 v[20:21], v[32:33], v[16:17], v[20:21] op_sel:[0,0,0] op_sel_hi:[1,0,1]
    v_pk_fma_f32 v[22:23], v[34:35], v[16:17], v[22:23] op_sel:[0,0,0] op_sel_hi:[1,0,1]
    v_pk_fma_f32 v[24:25], v[36:37], v[16:17], v[24:25] op_sel:[0,0,0] op_sel_hi:[1,0,1]
    v_pk_fma_f32 v[26:27], v[38:39], v[16:17], v[26:27] op_sel:[0,0,0] op_sel_hi:[1,0,1]
    v_add_f32 v29, v29, v16
    s_waitcnt vmcnt(5)
    s_cbranch_vccnz L_f13
    s_waitcnt vmcnt(4)
    s_cbranch_scc0 L_f13
    s_waitcnt vmcnt(3)
L_f13:
    buffer_load_dwordx4 v[60:63], v1, s[16:19], s44 offen nt
    s_waitcnt vmcnt(7)
    v_lshlrev_b32 v32, 16, v64
    v_and_b32 v33, s49, v64
    v_lshlrev_b32 v34, 16, v65
    v_and_b32 v35, s49, v65
    v_lshlrev_b32 v36, 16, v66
    v_and_b32 v37, s49, v66
    v_lshlrev_b32 v38, 16, v67
    v_and_b32 v39, s49, v67
    v_pk_fma_f32 v[20:21], v[32:33], v[16:17], v[20:21] op_sel:[0,1,0] op_sel_hi:[1,1,1]
    v_pk_fma_f32 v[22:23], v[34:35], v[16:17], v[22:23] op_sel:[0,1,0] op_sel_hi:[1,1,1]
    v_pk_fma_f32 v[24:25], v[36:37], v[16:17], v[24:25] op_sel:[0,1,0] op_sel_hi:[1,1,1]
    v_pk_fma_f32 v[26:27], v[38:39], v[16:17], v[26:27] op_sel:[0,1,0] op_sel_hi:[1,1,1]
    v_add_f32 v29, v29, v17
    s_waitcnt vmcnt(5)
    s_cbranch_vccnz L_f14
    s_waitcnt vmcnt(4)
    s_cbranch_scc0 L_f14
    s_waitcnt vmcnt(3)
L_f14:
    buffer_load_dwordx4 v[64:67], v1, s[16:19], s45 offen nt
    s_waitcnt vmcnt(7)
    v_lshlrev_b32 v32, 16, v68
    v_and_b32 v33, s49, v68
    v_lshlrev_b32 v34, 16, v69
    v_and_b32 v35, s49, v69
    v_lshlrev_b32 v36, 16, v70
    v_and_b32 v37, s49, v70
    v_lshlrev_b32 v38, 16, v71
    v_and_b32 v39, s49, v71
    v_pk_fma_f32 v[20:21], v[32:33], v[18:19], v[20:21] op_sel:[0,0,0] op_sel_hi:[1,0,1]
    v_pk_fma_f32 v[22:23], v[34:35], v[18:19], v[22:23] op_sel:[0,0,0] op_sel_hi:[1,0,1]
    v_pk_fma_f32 v[24:25], v[36:37], v[18:19], v[24:25] op_sel:[0,0,0] op_sel_hi:[1,0,1]
    v_pk_fma_f32 v[26:27], v[38:39], v[18:19], v[26:27] op_sel:[0,0,0] op_sel_hi:[1,0,1]
    v_add_f32 v29, v29, v18
    s_waitcnt vmcnt(5)
    s_cbranch_vccnz L_f15
    s_waitcnt vmcnt(4)
    s_cbranch_scc0 L_f15
    s_waitcnt vmcnt(3)
L_f15:
    buffer_load_dwordx4 v[68:71], v1, s[16:19], s46 offen nt
    s_waitcnt vmcnt(7)
    v_lshlrev_b32 v32, 16, v72
    v_and_b32 v33, s49, v72
    v_lshlrev_b32 v34, 16, v73
    v_and_b32 v35, s49, v73
    v_lshlrev_b32 v36, 16, v74
    v_and_b32 v37, s49, v74
    v_lshlrev_b32 v38, 16, v75
    v_and_b32 v39, s49, v75
    v_pk_fma_f32 v[20:21], v[32:33], v[18:19], v[20:21] op_sel:[0,1,0] op_sel_hi:[1,1,1]
    v_pk_fma_f32 v[22:23], v[34:35], v[18:19], v[22:23] op_sel:[0,1,0] op_sel_hi:[1,1,1]
    v_pk_fma_f32 v[24:25], v[36:37], v[18:19], v[24:25] op_sel:[0,1,0] op_sel_hi:[1,1,1]
    v_pk_fma_f32 v[26:27], v[38:39], v[18:19], v[26:27] op_sel:[0,1,0] op_sel_hi:[1,1,1]
    v_add_f32 v29, v29, v19
    s_waitcnt vmcnt(5)
    s_cbranch_vccnz L_f16
    s_waitcnt vmcnt(4)
    s_cbranch_scc0 L_f16
    s_waitcnt vmcnt(3)
L_f16:
    buffer_load_dwordx4 v[72:75], v1, s[16:19], s47 offen nt
    v_add_u32 v3, 128, v3
    s_or_b32 s23, s23, 0xfff13fff
    s_add_u32 s23, s23, 1
    s_and_b32 s23, s23, 0xec000
    s_cselect_b64 s[36:37], s[36:37], s[30:31]
    s_xor_b32 s21, s23, s22
    s_add_u32 s16, s36, s21
    s_addc_u32 s17, s37, 0
    s_sub_u32 s34, s34, 1
    s_cmp_lg_u32 s34, 0
    s_cbranch_scc1 L_vloop
    s_cmp_eq_u32 s32, 1
    s_cbranch_scc1 L_vtail
    ds_write_b128 v4, v[20:23] offset:16384
    ds_write_b128 v4, v[24:27] offset:16400
    ds_write_b64 v5, v[28:29] offset:32768
    s_mov_b32 s32, 1
    v_add_u32 v4, 8192, v4
    v_add_u32 v5, 128, v5
    s_mov_b32 s34, 15
    v_mov_b32 v28, v31
    s_branch L_vhead
L_vtail:
    v_and_b32 v76, 127, v0
    v_lshrrev_b32 v77, 7, v0
    v_lshlrev_b32 v76, 2, v76
    v_lshl_add_u32 v76, v77, 13, v76
    v_lshrrev_b32 v78, 1, v2
    v_lshl_add_u32 v77, v77, 7, v78
    v_lshlrev_b32 v40, 1, v0
L_vloop2:
    s_waitcnt lgkmcnt(0)
    v_sub_f32 v12, v12, v28
    v_sub_f32 v13, v13, v28
    v_sub_f32 v14, v14, v28
    v_sub_f32 v15, v15, v28
    ds_read_b128 v[16:19], v3 offset:64
    v_exp_f32 v12, v12
    v_exp_f32 v13, v13
    v_exp_f32 v14, v14
    v_exp_f32 v15, v15
    s_waitcnt vmcnt(7)
    v_lshlrev_b32 v32, 16, v44
    v_and_b32 v33, s49, v44
    v_lshlrev_b32 v34, 16, v45
    v_and_b32 v35, s49, v45
    v_lshlrev_b32 v36, 16, v46
    v_and_b32 v37, s49, v46
    v_lshlrev_b32 v38, 16, v47
    v_and_b32 v39, s49, v47
    v_pk_fma_f32 v[20:21], v[32:33], v[12:13], v[20:21] op_sel:[0,0,0] op_sel_hi:[1,0,1]
    v_pk_fma_f32 v[22:23], v[34:35], v[12:13], v[22:23] op_sel:[0,0,0] op_sel_hi:[1,0,1]
    v_pk_fma_f32 v[24:25], v[36:37], v[12:13], v[24:25] op_sel:[0,0,0] op_sel_hi:[1,0,1]
    v_pk_fma_f32 v[26:27], v[38:39], v[12:13], v[26:27] op_sel:[0,0,0] op_sel_hi:[1,0,1]
    v_add_f32 v29, v29, v12
    s_waitcnt vmcnt(6)
    v_lshlrev_b32 v32, 16, v48
    v_and_b32 v33, s49, v48
    v_lshlrev_b32 v34, 16, v49
    v_and_b32 v35, s49, v49
    v_lshlrev_b32 v36, 16, v50
    v_and_b32 v37, s49, v50
    v_lshlrev_b32 v38, 16, v51
    v_and_b32 v39, s49, v51
    v_pk_fma_f32 v[20:21], v[32:33], v[12:13], v[20:21] op_sel:[0,1,0] op_sel_hi:[1,1,1]
    v_pk_fma_f32 v[22:23], v[34:35], v[12:13], v[22:23] op_sel:[0,1,0] op_sel_hi:[1,1,1]
    v_pk_fma_f32 v[24:25], v[36:37], v[12:13], v[24:25] op_sel:[0,1,0] op_sel_hi:[1,1,1]
    v_pk_fma_f32 v[26:27], v[38:39], v[12:13], v[26:27] op_sel:[0,1,0] op_sel_hi:[1,1,1]
    v_add_f32 v29, v29, v13
    s_waitcnt vmcnt(5)
    v_lshlrev_b32 v32, 16, v52
    v_and_b32 v33, s49, v52
    v_lshlrev_b32 v34, 16, v53
    v_and_b32 v35, s49, v53
    v_lshlrev_b32 v36, 16, v54
    v_and_b32 v37, s49, v54
    v_lshlrev_b32 v38, 16, v55
    v_and_b32 v39, s49, v55
    v_pk_fma_f32 v[20:21], v[32:33], v[14:15], v[20:21] op_sel:[0,0,0] op_sel_hi:[1,0,1]
    v_pk_fma_f32 v[22:23], v[34:35], v[14:15], v[22:23] op_sel:[0,0,0] op_sel_hi:[1,0,1]
    v_pk_fma_f32 v[24:25], v[36:37], v[14:15], v[24:25] op_sel:[0,0,0] op_sel_hi:[1,0,1]
    v_pk_fma_f32 v[26:27], v[38:39], v[14:15], v[26:27] op_sel:[0,0,0] op_sel_hi:[1,0,1]
    v_add_f32 v29, v29, v14
    s_waitcnt vmcnt(4)
    v_lshlrev_b32 v32, 16, v56
    v_and_b32 v33, s49, v56
    v_lshlrev_b32 v34, 16, v57
    v_and_b32 v35, s49, v57
    v_lshlrev_b32 v36, 16, v58
    v_and_b32 v37, s49, v58
    v_lshlrev_b32 v38, 16, v59
    v_and_b32 v39, s49, v59
    v_pk_fma_f32 v[20:21], v[32:33], v[14:15], v[20:21] op_sel:[0,1,0] op_sel_hi:[1,1,1]
    v_pk_fma_f32 v[22:23], v[34:35], v[14:15], v[22:23] op_sel:[0,1,0] op_sel_hi:[1,1,1]
    v_pk_fma_f32 v[24:25], v[36:37], v[14:15], v[24:25] op_sel:[0,1,0] op_sel_hi:[1,1,1]
    v_pk_fma_f32 v[26:27], v[38:39], v[14:15], v[26:27] op_sel:[0,1,0] op_sel_hi:[1,1,1]
    v_add_f32 v29, v29, v15
    s_waitcnt lgkmcnt(0)
    v_sub_f32 v16, v16, v28
    v_sub_f32 v17, v17, v28
    v_sub_f32 v18, v18, v28
    v_sub_f32 v19, v19, v28
    v_exp_f32 v16, v16
    v_exp_f32 v17, v17
    v_exp_f32 v18, v18
    v_exp_f32 v19, v19
    s_waitcnt vmcnt(3)
    v_lshlrev_b32 v32, 16, v60
    v_and_b32 v33, s49, v60
    v_lshlrev_b32 v34, 16, v61
    v_and_b32 v35, s49, v61
    v_lshlrev_b32 v36, 16, v62
    v_and_b32 v37, s49, v62
    v_lshlrev_b32 v38, 16, v63
    v_and_b32 v39, s49, v63
    v_pk_fma_f32 v[20:21], v[32:33], v[16:17], v[20:21] op_sel:[0,0,0] op_sel_hi:[1,0,1]
    v_pk_fma_f32 v[22:23], v[34:35], v[16:17], v[22:23] op_sel:[0,0,0] op_sel_hi:[1,0,1]
    v_pk_fma_f32 v[24:25], v[36:37], v[16:17], v[24:25] op_sel:[0,0,0] op_sel_hi:[1,0,1]
    v_pk_fma_f32 v[26:27], v[38:39], v[16:17], v[26:27] op_sel:[0,0,0] op_sel_hi:[1,0,1]
    v_add_f32 v29, v29, v16
    s_waitcnt vmcnt(2)
    v_lshlrev_b32 v32, 16, v64
    v_and_b32 v33, s49, v64
    v_lshlrev_b32 v34, 16, v65
    v_and_b32 v35, s49, v65
    v_lshlrev_b32 v36, 16, v66
    v_and_b32 v37, s49, v66
    v_lshlrev_b32 v38, 16, v67
    v_and_b32 v39, s49, v67
    v_pk_fma_f32 v[20:21], v[32:33], v[16:17], v[20:21] op_sel:[0,1,0] op_sel_hi:[1,1,1]
    v_pk_fma_f32 v[22:23], v[34:35], v[16:17], v[22:23] op_sel:[0,1,0] op_sel_hi:[1,1,1]
    v_pk_fma_f32 v[24:25], v[36:37], v[16:17], v[24:25] op_sel:[0,1,0] op_sel_hi:[1,1,1]
    v_pk_fma_f32 v[26:27], v[38:39], v[16:17], v[26:27] op_sel:[0,1,0] op_sel_hi:[1,1,1]
    v_add_f32 v29, v29, v17
    s_waitcnt vmcnt(1)
    v_lshlrev_b32 v32, 16, v68
    v_and_b32 v33, s49, v68
    v_lshlrev_b32 v34, 16, v69
    v_and_b32 v35, s49, v69
    v_lshlrev_b32 v36, 16, v70
    v_and_b32 v37, s49, v70
    v_lshlrev_b32 v38, 16, v71
    v_and_b32 v39, s49, v71
    v_pk_fma_f32 v[20:21], v[32:33], v[18:19], v[20:21] op_sel:[0,0,0] op_sel_hi:[1,0,1]
    v_pk_fma_f32 v[22:23], v[34:35], v[18:19], v[22:23] op_sel:[0,0,0] op_sel_hi:[1,0,1]
    v_pk_fma_f32 v[24:25], v[36:37], v[18:19], v[24:25] op_sel:[0,0,0] op_sel_hi:[1,0,1]
    v_pk_fma_f32 v[26:27], v[38:39], v[18:19], v[26:27] op_sel:[0,0,0] op_sel_hi:[1,0,1]
    v_add_f32 v29, v29, v18
    s_waitcnt vmcnt(0)
    v_lshlrev_b32 v32, 16, v72
    v_and_b32 v33, s49, v72
    v_lshlrev_b32 v34, 16, v73
    v_and_b32 v35, s49, v73
    v_lshlrev_b32 v36, 16, v74
    v_and_b32 v37, s49, v74
    v_lshlrev_b32 v38, 16, v75
    v_and_b32 v39, s49, v75
    v_pk_fma_f32 v[20:21], v[32:33], v[18:19], v[20:21] op_sel:[0,1,0] op_sel_hi:[1,1,1]
    v_pk_fma_f32 v[22:23], v[34:35], v[18:19], v[22:23] op_sel:[0,1,0] op_sel_hi:[1,1,1]
    v_pk_fma_f32 v[24:25], v[36:37], v[18:19], v[24:25] op_sel:[0,1,0] op_sel_hi:[1,1,1]
    v_pk_fma_f32 v[26:27], v[38:39], v[18:19], v[26:27] op_sel:[0,1,0] op_sel_hi:[1,1,1]
    v_add_f32 v29, v29, v19
    ds_write_b128 v4, v[20:23] offset:16384
    ds_write_b128 v4, v[24:27] offset:16400
    ds_write_b64 v5, v[28:29] offset:32768
    s_waitcnt lgkmcnt(0)
    s_barrier
    ds_read_b64 v[78:79], v77 offset:32768
    ds_read2st64_b32 v[80:81], v76 offset0:64 offset1:66
    ds_read2st64_b32 v[82:83], v76 offset0:68 offset1:70
    ds_read2st64_b32 v[84:85], v76 offset0:72 offset1:74
    ds_read2st64_b32 v[86:87], v76 offset0:76 offset1:78
    ds_read2st64_b32 v[88:89], v76 offset0:80 offset1:82
    ds_read2st64_b32 v[90:91], v76 offset0:84 offset1:86
    ds_read2st64_b32 v[92:93], v76 offset0:88 offset1:90
    ds_read2st64_b32 v[94:95], v76 offset0:92 offset1:94
    s_waitcnt lgkmcnt(8)
    v_mov_b32 v32, v78
    s_nop 1
    v_max_f32_dpp v32, v32, v32 row_ror:8 row_mask:0xf bank_mask:0xf
    s_nop 1
    v_max_f32_dpp v32, v32, v32 row_ror:4 row_mask:0xf bank_mask:0xf
    s_nop 1
    v_max_f32_dpp v32, v32, v32 row_ror:2 row_mask:0xf bank_mask:0xf
    s_nop 1
    v_max_f32_dpp v32, v32, v32 row_ror:1 row_mask:0xf bank_mask:0xf
    v_sub_f32 v78, v78, v32
    v_exp_f32 v78, v78
    s_nop 0
    v_mul_f32 v32, v78, v79
    s_waitcnt lgkmcnt(0)
    v_mul_f32_dpp v34, v78, v80 row_newbcast:0 row_mask:0xf bank_mask:0xf
    v_mul_f32_dpp v35, v78, v81 row_newbcast:1 row_mask:0xf bank_mask:0xf
    v_mul_f32_dpp v36, v78, v82 row_newbcast:2 row_mask:0xf bank_mask:0xf
    v_add_f32_dpp v32, v32, v32 row_ror:8 row_mask:0xf bank_mask:0xf
    v_mul_f32_dpp v37, v78, v83 row_newbcast:3 row_mask:0xf bank_mask:0xf
    v_fmac_f32_dpp v34, v78, v84 row_newbcast:4 row_mask:0xf bank_mask:0xf
    v_fmac_f32_dpp v35, v78, v85 row_newbcast:5 row_mask:0xf bank_mask:0xf
    v_add_f32_dpp v32, v32, v32 row_ror:4 row_mask:0xf bank_mask:0xf
    v_fmac_f32_dpp v36, v78, v86 row_newbcast:6 row_mask:0xf bank_mask:0xf
    v_fmac_f32_dpp v37, v78, v87 row_newbcast:7 row_mask:0xf bank_mask:0xf
    v_fmac_f32_dpp v34, v78, v88 row_newbcast:8 row_mask:0xf bank_mask:0xf
    v_add_f32_dpp v32, v32, v32 row_ror:2 row_mask:0xf bank_mask:0xf
    v_fmac_f32_dpp v35, v78, v89 row_newbcast:9 row_mask:0xf bank_mask:0xf
    v_fmac_f32_dpp v36, v78, v90 row_newbcast:10 row_mask:0xf bank_mask:0xf
    v_fmac_f32_dpp v37, v78, v91 row_newbcast:11 row_mask:0xf bank_mask:0xf
    v_add_f32_dpp v32, v32, v32 row_ror:1 row_mask:0xf bank_mask:0xf
    v_rcp_f32 v32, v32
    v_fmac_f32_dpp v34, v78, v92 row_newbcast:12 row_mask:0xf bank_mask:0xf
    v_fmac_f32_dpp v35, v78, v93 row_newbcast:13 row_mask:0xf bank_mask:0xf
    v_fmac_f32_dpp v36, v78, v94 row_newbcast:14 row_mask:0xf bank_mask:0xf
    v_fmac_f32_dpp v37, v78, v95 row_newbcast:15 row_mask:0xf bank_mask:0xf
    v_pk_add_f32 v[34:35], v[34:35], v[36:37]
    v_add_f32 v33, v34, v35
    v_mul_f32 v33, v33, v32
    v_cvt_pk_bf16_f32 v33, v33, v33
    buffer_store_short v33, v40, s[24:27], 0 offen
L_done:
    s_endpgm
L_ctl:
    s_memrealtime s[52:53]
    v_and_b32 v8, 3, v0
    v_lshlrev_b32 v8, 2, v8
    v_mov_b32 v5, 0
    v_mov_b32 v6, 0
    v_mov_b32 v12, 1
    s_waitcnt lgkmcnt(0)
    s_barrier
    s_mov_b32 s40, 4
    s_mov_b32 s41, 0
    s_and_b32 s46, s48, 7
    s_lshr_b32 s39, s48, 7
    s_lshl_b32 s39, s39, 3
    s_or_b32 s39, s39, s46
    s_lshl_b32 s39, s39, 8
    s_and_b32 s47, s48, 0x78
    s_mov_b64 exec, 15
    s_mov_b32 s57, 0
L_cnext:
    s_mov_b32 s42, 15
L_cp1:
    s_sleep 2
    ds_read_b32 v4, v8 offset:33024
    s_waitcnt lgkmcnt(0)
    v_cmp_lt_u32 vcc, v4, v5
    s_nop 1
    v_cndmask_b32 v7, 0, v12, vcc
    v_cmp_gt_u32 vcc, s40, v4
    ds_write_b32 v8, v7 offset:33040
    s_andn2_b32 s56, exec_lo, vcc_lo
    s_and_b32 s56, s56, s42
    s_cbranch_scc0 L_cp1
    s_memrealtime s[54:55]
    s_mov_b32 s42, vcc_lo
    s_waitcnt lgkmcnt(0)
    s_sub_u32 s46, s54, s52
    v_mov_b32 v9, s46
    v_cndmask_b32 v6, v6, v9, s[56:57]
    s_cbranch_vccnz L_cp1
    s_cmp_lg_u32 s47, 0
    s_cbranch_scc1 L_cnb
    s_nop 1
    v_add_u32_dpp v10, v6, v6 quad_perm:[1,0,3,2] row_mask:0xf bank_mask:0xf
    s_add_u32 s46, s41, s39
    v_mov_b32 v9, s46
    v_add_u32_dpp v10, v10, v10 quad_perm:[2,3,0,1] row_mask:0xf bank_mask:0xf
    v_mov_b32 v11, s53
    v_lshrrev_b32 v10, 2, v10
    v_add_u32 v10, s52, v10
    s_mov_b64 exec, 1
    global_store_dwordx2 v9, v[10:11], s[50:51] sc0 sc1
    s_mov_b64 exec, 15
L_cnb:
    s_add_u32 s38, s40, 2
L_cp2:
    s_sleep 2
    ds_read_b32 v4, v8 offset:33024
    s_waitcnt lgkmcnt(0)
    v_cmp_lt_u32 vcc, v4, v5
    s_nop 1
    v_cndmask_b32 v7, 0, v12, vcc
    v_cmp_gt_u32 vcc, s38, v4
    ds_write_b32 v8, v7 offset:33040
    s_cbranch_vccnz L_cp2
    s_add_u32 s60, s50, s41
    s_addc_u32 s61, s51, 0
    s_load_dwordx2 s[64:65], s[60:61], 0
    s_load_dwordx2 s[66:67], s[60:61], 256
    s_load_dwordx2 s[68:69], s[60:61], 512
    s_load_dwordx2 s[70:71], s[60:61], 768
    s_load_dwordx2 s[72:73], s[60:61], 1024
    s_load_dwordx2 s[74:75], s[60:61], 1280
    s_load_dwordx2 s[76:77], s[60:61], 1536
    s_load_dwordx2 s[78:79], s[60:61], 1792
    s_load_dwordx2 s[80:81], s[60:61], 2048
    s_load_dwordx2 s[82:83], s[60:61], 2304
    s_load_dwordx2 s[84:85], s[60:61], 2560
    s_load_dwordx2 s[86:87], s[60:61], 2816
    s_load_dwordx2 s[88:89], s[60:61], 3072
    s_load_dwordx2 s[90:91], s[60:61], 3328
    s_load_dwordx2 s[92:93], s[60:61], 3584
    s_load_dwordx2 s[94:95], s[60:61], 3840
    s_mov_b32 s44, 0
    s_mov_b32 s46, 0
    s_waitcnt lgkmcnt(0)
    s_sub_u32 s58, s64, s52
    s_xor_b32 s59, s65, s53
    s_cselect_b32 s58, -1, s58
    s_cmp_lt_u32 s58, 20000
    s_cselect_b32 s58, s58, 0
    s_addc_u32 s46, s46, 0
    s_add_u32 s44, s44, s58
    s_sub_u32 s58, s66, s52
    s_xor_b32 s59, s67, s53
    s_cselect_b32 s58, -1, s58
    s_cmp_lt_u32 s58, 20000
    s_cselect_b32 s58, s58, 0
    s_addc_u32 s46, s46, 0
    s_add_u32 s44, s44, s58
    s_sub_u32 s58, s68, s52
    s_xor_b32 s59, s69, s53
    s_cselect_b32 s58, -1, s58
    s_cmp_lt_u32 s58, 20000
    s_cselect_b32 s58, s58, 0
    s_addc_u32 s46, s46, 0
    s_add_u32 s44, s44, s58
    s_sub_u32 s58, s70, s52
    s_xor_b32 s59, s71, s53
    s_cselect_b32 s58, -1, s58
    s_cmp_lt_u32 s58, 20000
    s_cselect_b32 s58, s58, 0
    s_addc_u32 s46, s46, 0
    s_add_u32 s44, s44, s58
    s_sub_u32 s58, s72, s52
    s_xor_b32 s59, s73, s53
    s_cselect_b32 s58, -1, s58
    s_cmp_lt_u32 s58, 20000
    s_cselect_b32 s58, s58, 0
    s_addc_u32 s46, s46, 0
    s_add_u32 s44, s44, s58
    s_sub_u32 s58, s74, s52
    s_xor_b32 s59, s75, s53
    s_cselect_b32 s58, -1, s58
    s_cmp_lt_u32 s58, 20000
    s_cselect_b32 s58, s58, 0
    s_addc_u32 s46, s46, 0
    s_add_u32 s44, s44, s58
    s_sub_u32 s58, s76, s52
    s_xor_b32 s59, s77, s53
    s_cselect_b32 s58, -1, s58
    s_cmp_lt_u32 s58, 20000
    s_cselect_b32 s58, s58, 0
    s_addc_u32 s46, s46, 0
    s_add_u32 s44, s44, s58
    s_sub_u32 s58, s78, s52
    s_xor_b32 s59, s79, s53
    s_cselect_b32 s58, -1, s58
    s_cmp_lt_u32 s58, 20000
    s_cselect_b32 s58, s58, 0
    s_addc_u32 s46, s46, 0
    s_add_u32 s44, s44, s58
    s_sub_u32 s58, s80, s52
    s_xor_b32 s59, s81, s53
    s_cselect_b32 s58, -1, s58
    s_cmp_lt_u32 s58, 20000
    s_cselect_b32 s58, s58, 0
    s_addc_u32 s46, s46, 0
    s_add_u32 s44, s44, s58
    s_sub_u32 s58, s82, s52
    s_xor_b32 s59, s83, s53
    s_cselect_b32 s58, -1, s58
    s_cmp_lt_u32 s58, 20000
    s_cselect_b32 s58, s58, 0
    s_addc_u32 s46, s46, 0
    s_add_u32 s44, s44, s58
    s_sub_u32 s58, s84, s52
    s_xor_b32 s59, s85, s53
    s_cselect_b32 s58, -1, s58
    s_cmp_lt_u32 s58, 20000
    s_cselect_b32 s58, s58, 0
    s_addc_u32 s46, s46, 0
    s_add_u32 s44, s44, s58
    s_sub_u32 s58, s86, s52
    s_xor_b32 s59, s87, s53
    s_cselect_b32 s58, -1, s58
    s_cmp_lt_u32 s58, 20000
    s_cselect_b32 s58, s58, 0
    s_addc_u32 s46, s46, 0
    s_add_u32 s44, s44, s58
    s_sub_u32 s58, s88, s52
    s_xor_b32 s59, s89, s53
    s_cselect_b32 s58, -1, s58
    s_cmp_lt_u32 s58, 20000
    s_cselect_b32 s58, s58, 0
    s_addc_u32 s46, s46, 0
    s_add_u32 s44, s44, s58
    s_sub_u32 s58, s90, s52
    s_xor_b32 s59, s91, s53
    s_cselect_b32 s58, -1, s58
    s_cmp_lt_u32 s58, 20000
    s_cselect_b32 s58, s58, 0
    s_addc_u32 s46, s46, 0
    s_add_u32 s44, s44, s58
    s_sub_u32 s58, s92, s52
    s_xor_b32 s59, s93, s53
    s_cselect_b32 s58, -1, s58
    s_cmp_lt_u32 s58, 20000
    s_cselect_b32 s58, s58, 0
    s_addc_u32 s46, s46, 0
    s_add_u32 s44, s44, s58
    s_sub_u32 s58, s94, s52
    s_xor_b32 s59, s95, s53
    s_cselect_b32 s58, -1, s58
    s_cmp_lt_u32 s58, 20000
    s_cselect_b32 s58, s58, 0
    s_addc_u32 s46, s46, 0
    s_add_u32 s44, s44, s58
    v_mul_u32_u24 v9, s46, v6
    v_subrev_u32 v9, s44, v9
    v_mov_b32 v7, 0
    s_mul_i32 s59, s46, 25
    v_cmp_lt_i32 vcc, s59, v9
    s_nop 1
    v_cndmask_b32 v7, v7, 1, vcc
    s_mul_i32 s59, s46, 55
    v_cmp_lt_i32 vcc, s59, v9
    s_nop 1
    v_cndmask_b32 v7, v7, 2, vcc
    s_mul_i32 s59, s46, 90
    v_cmp_lt_i32 vcc, s59, v9
    s_nop 1
    v_cndmask_b32 v7, v7, 4, vcc
    v_mov_b32 v12, 1
    s_mul_i32 s59, s46, -25
    v_cmp_gt_i32 vcc, s59, v9
    s_nop 1
    v_cndmask_b32 v7, v7, 1, vcc
    v_cndmask_b32 v12, v12, 2, vcc
    s_mul_i32 s59, s46, -60
    v_cmp_gt_i32 vcc, s59, v9
    s_nop 1
    v_cndmask_b32 v7, v7, 2, vcc
    v_cndmask_b32 v12, v12, 2, vcc
    v_add_u32 v5, v4, v7
    s_add_u32 s40, s40, 4
    s_add_u32 s41, s41, 4096
    s_cmp_le_u32 s40, 56
    s_cbranch_scc1 L_cnext
    v_cmp_lt_u32 vcc, v4, v5
    s_nop 1
    v_cndmask_b32 v7, 0, v12, vcc
    v_and_b32 v7, 1, v7
    ds_write_b32 v8, v7 offset:33040
    s_endpgm
.section .rodata,"a"
.p2align 6
.amdhsa_kernel standalone__mha_softmax__sampling_kernel
  .amdhsa_next_free_vgpr 96
  .amdhsa_next_free_sgpr 96
  .amdhsa_accum_offset 96
  .amdhsa_group_segment_fixed_size 0
  .amdhsa_kernarg_size 48
  .amdhsa_user_sgpr_count 2
  .amdhsa_user_sgpr_kernarg_segment_ptr 1
  .amdhsa_system_sgpr_workgroup_id_x 1
  .amdhsa_float_denorm_mode_32 3
.end_amdhsa_kernel
```
